```python
import torch

def _softmax(x, axis=-1):
    return torch.softmax(x, dim=axis)
def _gelu(x):
    return torch.nn.functional.gelu(x, approximate="tanh")
def _silu(x):
    return torch.nn.functional.silu(x)
def _sigmoid(x):
    return torch.sigmoid(x)
def _layernorm(x, axis=-1, eps=1e-5):
    m = x.mean(dim=axis, keepdim=True)
    v = x.var(dim=axis, keepdim=True, unbiased=False)
    return (x - m) / torch.sqrt(v + eps)
def _scatter_add(tgt, idx, src, axis=0):
    return tgt.clone().index_add_(axis, idx, src)
def _segment_sum(src, seg, n):
    out = torch.zeros((n,) + src.shape[1:], dtype=src.dtype)
    return out.index_add_(0, seg, src)
def _pad(x, pw):
    flat = tuple(v for pair in reversed(pw) for v in pair)
    return torch.nn.functional.pad(x, flat)

kernel_name = 'gated_mix__mha_block_cached__dense_activation_squared_relu__decode'

def setup_inputs():

    _w = (lambda a: (lambda t: t.to(torch.bfloat16) if t.is_floating_point() else t)(torch.as_tensor(a)))
    def _A_setup():
        B, Sq, D = 2, 1, 448
        H, Sk, Dh = 16, 4096, 256
        return {
            "x": _w((lambda *s: torch.randn(*s, dtype=torch.bfloat16) * 0.05)(B, Sq, D)),
            "k_cache": _w((lambda *s: torch.randn(*s, dtype=torch.bfloat16) * 6.4)(B, H, Sk, Dh)),
            "v_cache": _w((lambda *s: torch.randn(*s, dtype=torch.bfloat16) * 3.2)(B, H, Sk, Dh)),
            "wq": _w((lambda *s: torch.randn(*s, dtype=torch.bfloat16) * 6.4)(D, H * Dh) * (D ** -0.5)),
            "wo": _w((lambda *s: torch.randn(*s, dtype=torch.bfloat16) * 3.2)(H * Dh, D) * ((H * Dh) ** -0.5)),
        }
    _A_in = _A_setup()

    def _B_setup():
        B, S, D, F = 2, 1, 448, 1792
        return {
            "x": _w((lambda *s: torch.randn(*s, dtype=torch.bfloat16) * 0.05)(B, S, D)),
            "w1": _w((lambda *s: torch.randn(*s, dtype=torch.bfloat16) * 0.2)(D, F)),
            "b1": _w((lambda *s: torch.randn(*s, dtype=torch.bfloat16) * 0.2)(F)),
            "w2": _w((lambda *s: torch.randn(*s, dtype=torch.bfloat16) * 0.2)(F, D)),
            "b2": _w((lambda *s: torch.randn(*s, dtype=torch.bfloat16) * 0.4)(D)),
        }
    _B_in = _B_setup()

    return {
        "A_x": _A_in["x"],
        "A_k_cache": _A_in["k_cache"],
        "A_v_cache": _A_in["v_cache"],
        "A_wq": _A_in["wq"],
        "A_wo": _A_in["wo"],
        "B_x": _B_in["x"],
        "B_w1": _B_in["w1"],
        "B_b1": _B_in["b1"],
        "B_w2": _B_in["w2"],
        "B_b2": _B_in["b2"],
        "gate_w": _w((lambda *s: torch.randn(*s, dtype=torch.bfloat16) * 0.1)(448) * 16.0),
    }

def reference(A_x, A_k_cache, A_v_cache, A_wq, A_wo, B_x, B_w1, B_b1, B_w2, B_b2, gate_w):
    def _A_ref(x, k_cache, v_cache, wq, wo):
        B, Sq, D = x.shape
        H, Dh = 16, 256
        q = (lambda x, *d: x.permute(*d))((x @ wq).reshape(B, Sq, H, Dh), 0, 2, 1, 3)
        scores = torch.einsum("bhqd,bhkd->bhqk", q, k_cache) * (Dh ** -0.5)
        p = _softmax(scores, axis=-1)
        o = torch.einsum("bhqk,bhkd->bhqd", p, v_cache)
        return (lambda x, *d: x.permute(*d))(o, 0, 2, 1, 3).reshape(B, Sq, H * Dh) @ wo

    def _B_ref(x, w1, b1, w2, b2):
        h = torch.einsum("bsd,df->bsf", x, w1) + b1
        zero = torch.zeros_like(h)
        r = torch.where(h > zero, h, zero)
        h = r * r
        out = torch.einsum("bsf,fd->bsd", h, w2) + b2
        return out

    x = A_x
    g = _sigmoid((x * gate_w).sum(-1, keepdims=True))
    a = _A_ref(x, A_k_cache, A_v_cache, A_wq, A_wo)
    b = _B_ref(x, B_w1, B_b1, B_w2, B_b2)
    return g * a + (1 - g) * b
```

```asm
; @launch grid=(256,1,1) block=(1024,1,1) lds=22528
.amdgcn_target "amdgcn-amd-amdhsa--gfx950"
.text
.globl gated_mix__mha_block_cached__dense_activation_squared_relu__decode_kernel
.p2align 8
.type gated_mix__mha_block_cached__dense_activation_squared_relu__decode_kernel,@function
gated_mix__mha_block_cached__dense_activation_squared_relu__decode_kernel:
    s_cmp_ge_u32 s2, 256
    s_cbranch_scc1 L_end
    s_load_dwordx16 s[16:31], s[0:1], 0
    s_load_dwordx8 s[32:39], s[0:1], 64
    s_load_dwordx2 s[42:43], s[0:1], 104
    v_lshrrev_b32 v127, 6, v0
    v_and_b32 v126, 63, v0
    s_and_b32 s3, s2, 7
    v_readfirstlane_b32 s10, v127
    s_lshr_b32 s4, s2, 3
    s_and_b32 s5, s4, 15
    s_lshr_b32 s6, s4, 4
    s_xor_b32 s7, s3, 0
    s_lshl_b32 s8, s6, 3
    s_add_u32 s8, s8, s7
    s_lshl_b32 s9, s6, 4
    s_add_u32 s9, s9, s5
    s_and_b32 s11, s7, 1
    s_lshl_b32 s11, s11, 4
    s_xor_b32 s93, s5, 0
    s_or_b32 s11, s11, s93
    s_cmp_lt_u32 s11, 14
    s_cselect_b32 s63, 1, 0
    v_and_b32 v120, 15, v126
    v_lshrrev_b32 v121, 4, v126
    v_and_b32 v127, 7, v126
    v_lshlrev_b32 v124, 9, v127
    v_lshl_add_u32 v124, v121, 4, v124
    v_and_b32 v127, 8, v126
    v_lshl_add_u32 v124, v127, 3, v124
    s_lshr_b32 s13, s5, 2
    s_xor_b32 s13, s13, s10
    s_and_b32 s13, s13, 15
    s_lshl_b32 s13, s13, 14
    s_xor_b32 s14, s10, s5
    s_and_b32 s14, s14, 3
    s_lshl_b32 s12, s14, 12
    s_or_b32 s72, s13, s12
    s_xor_b32 s73, s72, 4096
    s_xor_b32 s74, s72, 8192
    s_xor_b32 s75, s72, 12288
    s_lshl_b32 s68, s9, 21
    s_lshl_b32 s12, s7, 18
    s_add_u32 s68, s68, s12
    s_mov_b32 s46, 262144
    s_mov_b32 s47, 0x00020000
    s_mov_b32 s50, 262144
    s_mov_b32 s51, 0x00020000
    s_mov_b32 s54, 2097152
    s_mov_b32 s55, 0x00020000
    s_mov_b32 s59, 0x00020000
    s_mov_b32 s79, 0xffff0000
    s_cmp_le_u32 s10, s63
    s_cbranch_scc1 L_stage1
    s_waitcnt lgkmcnt(0)
    s_add_u32 s44, s18, s68
    s_addc_u32 s45, s19, 0
    buffer_load_dwordx4 v[0:3], v124, s[44:47], s72 offen offset:0 nt
    buffer_load_dwordx4 v[4:7], v124, s[44:47], s72 offen offset:128 nt
    buffer_load_dwordx4 v[8:11], v124, s[44:47], s72 offen offset:256 nt
    buffer_load_dwordx4 v[12:15], v124, s[44:47], s72 offen offset:384 nt
    buffer_load_dwordx4 v[16:19], v124, s[44:47], s73 offen offset:0 nt
    buffer_load_dwordx4 v[20:23], v124, s[44:47], s73 offen offset:128 nt
    buffer_load_dwordx4 v[24:27], v124, s[44:47], s73 offen offset:256 nt
    buffer_load_dwordx4 v[28:31], v124, s[44:47], s73 offen offset:384 nt
    buffer_load_dwordx4 v[32:35], v124, s[44:47], s74 offen offset:0 nt
    buffer_load_dwordx4 v[36:39], v124, s[44:47], s74 offen offset:128 nt
    buffer_load_dwordx4 v[40:43], v124, s[44:47], s74 offen offset:256 nt
    buffer_load_dwordx4 v[44:47], v124, s[44:47], s74 offen offset:384 nt
    buffer_load_dwordx4 v[48:51], v124, s[44:47], s75 offen offset:0 nt
    buffer_load_dwordx4 v[52:55], v124, s[44:47], s75 offen offset:128 nt
    buffer_load_dwordx4 v[56:59], v124, s[44:47], s75 offen offset:256 nt
    buffer_load_dwordx4 v[60:63], v124, s[44:47], s75 offen offset:384 nt
    s_add_u32 s48, s20, s68
    s_addc_u32 s49, s21, 0
    s_mov_b32 s52, s42
    s_mov_b32 s53, s43
    v_and_b32 v100, 1, v126
    v_lshlrev_b32 v100, 4, v100
    v_mov_b32 v101, 0xffff
    v_lshlrev_b32 v101, v100, v101
    v_bfe_u32 v102, v126, 1, 2
    v_cmp_eq_u32 vcc, 0, v102
    s_mov_b32 s40, 117835008
    s_nop 0
    v_cndmask_b32 v96, 0, v101, vcc
    v_cmp_eq_u32 vcc, 1, v102
    s_mov_b32 s41, 117835009
    s_nop 0
    v_cndmask_b32 v97, 0, v101, vcc
    v_cmp_eq_u32 vcc, 2, v102
    s_mov_b32 s60, 117835010
    s_nop 0
    v_cndmask_b32 v98, 0, v101, vcc
    v_cmp_eq_u32 vcc, 3, v102
    s_mov_b32 s61, 117835011
    s_nop 0
    v_cndmask_b32 v99, 0, v101, vcc
    s_mov_b32 s3, 0x0c0c0400
    s_mov_b32 s4, 0x04000c0c
    s_movk_i32 s94, 0xff00
L_kdone:
    v_lshlrev_b32 v125, 11, v121
    v_lshl_add_u32 v125, v120, 4, v125
    s_and_b32 s12, s72, 4096
    v_xor_b32 v125, s12, v125
    s_andn2_b32 s76, s72, 4096
    s_xor_b32 s77, s76, 8192
    buffer_load_dwordx4 v[64:67], v125, s[48:51], s76 offen offset:0 nt
    buffer_load_dwordx4 v[68:71], v125, s[48:51], s76 offen offset:256 nt
    s_mov_b32 s78, 0x3db8aa3b
    s_movk_i32 s91, 3584
    s_lshr_b32 s85, s10, 2
    s_lshl_b32 s11, s5, 3
    s_add_u32 s11, s11, s7
    s_mul_i32 s11, s11, 28672
    s_lshl_b32 s12, s93, 3
    s_add_u32 s12, s12, s7
    s_mul_i32 s12, s12, 14336
    s_mul_i32 s12, s12, s63
    s_cmp_eq_u32 s85, 1
    s_cselect_b32 s11, s11, s12
    s_cselect_b32 s13, s24, s32
    s_cselect_b32 s14, s25, s33
    s_add_u32 s64, s13, s11
    s_addc_u32 s65, s14, 0
    s_mov_b32 s66, 28672
    s_mov_b32 s67, 0x00020000
    s_lshl_b32 s11, s63, 1
    s_cmp_eq_u32 s85, 2
    s_cselect_b32 s85, s11, s85
    v_and_b32 v127, 8, v126
    v_lshlrev_b32 v127, 3, v127
    v_lshl_add_u32 v127, v121, 4, v127
    v_mul_u32_u24 v124, 7168, v121
    v_lshl_add_u32 v124, v120, 4, v124
    s_and_b32 s11, s10, 3
    s_lshl_b32 s12, s11, 8
    v_add_u32 v124, s12, v124
    s_cmp_eq_u32 s11, 3
    s_cselect_b32 s11, 8, 0
    v_and_b32 v100, s11, v126
    v_lshl_or_b32 v124, v100, 27, v124
    s_lshl_b32 s86, s5, 2
    s_lshr_b32 s11, s7, 1
    s_add_u32 s86, s86, s11
    s_bitcmp1_b32 s7, 0
    s_cselect_b32 s86, s86, 99
    s_cmp_lg_u32 s10, 2
    s_cbranch_scc1 L_noz
    v_mov_b32 v100, 0
    v_mov_b32 v101, 0
    v_mov_b32 v102, 0
    v_mov_b32 v103, 0
    v_lshlrev_b32 v104, 4, v126
    ds_write_b128 v104, v[100:103] offset:21504
    ds_write_b32 v100, v100 offset:780
L_noz:
    s_waitcnt lgkmcnt(0)
    s_barrier
    ds_read_b128 v[80:83], v127 offset:0
    ds_read_b128 v[84:87], v127 offset:128
    ds_read_b128 v[88:91], v127 offset:256
    ds_read_b128 v[92:95], v127 offset:384
    s_sub_u32 s11, s85, 1
    s_waitcnt vmcnt(2)
    s_waitcnt lgkmcnt(3)
    v_mfma_f32_16x16x32_bf16 v[100:103], v[0:3], v[80:83], 0
    v_mfma_f32_16x16x32_bf16 v[104:107], v[16:19], v[80:83], 0
    v_mfma_f32_16x16x32_bf16 v[108:111], v[32:35], v[80:83], 0
    v_mfma_f32_16x16x32_bf16 v[112:115], v[48:51], v[80:83], 0
    s_waitcnt lgkmcnt(2)
    v_mfma_f32_16x16x32_bf16 v[100:103], v[4:7], v[84:87], v[100:103]
    v_mfma_f32_16x16x32_bf16 v[104:107], v[20:23], v[84:87], v[104:107]
    v_mfma_f32_16x16x32_bf16 v[108:111], v[36:39], v[84:87], v[108:111]
    v_mfma_f32_16x16x32_bf16 v[112:115], v[52:55], v[84:87], v[112:115]
    s_waitcnt lgkmcnt(1)
    v_mfma_f32_16x16x32_bf16 v[100:103], v[8:11], v[88:91], v[100:103]
    v_mfma_f32_16x16x32_bf16 v[104:107], v[24:27], v[88:91], v[104:107]
    v_mfma_f32_16x16x32_bf16 v[108:111], v[40:43], v[88:91], v[108:111]
    v_mfma_f32_16x16x32_bf16 v[112:115], v[56:59], v[88:91], v[112:115]
    s_waitcnt lgkmcnt(0)
    v_mfma_f32_16x16x32_bf16 v[100:103], v[12:15], v[92:95], v[100:103]
    v_mfma_f32_16x16x32_bf16 v[104:107], v[28:31], v[92:95], v[104:107]
    v_mfma_f32_16x16x32_bf16 v[108:111], v[44:47], v[92:95], v[108:111]
    v_mfma_f32_16x16x32_bf16 v[112:115], v[60:63], v[92:95], v[112:115]
    s_cmp_lg_u32 s11, 1
    s_cbranch_scc1 L_now
    buffer_load_dwordx4 v[32:35], v124, s[64:67], 0 offen offset:0
    buffer_load_dwordx4 v[36:39], v124, s[64:67], 0 offen offset:896
    buffer_load_dwordx4 v[40:43], v124, s[64:67], 0 offen offset:1792
    buffer_load_dwordx4 v[44:47], v124, s[64:67], 0 offen offset:2688
    buffer_load_dwordx4 v[48:51], v124, s[64:67], s91 offen offset:0
    buffer_load_dwordx4 v[52:55], v124, s[64:67], s91 offen offset:896
    buffer_load_dwordx4 v[56:59], v124, s[64:67], s91 offen offset:1792
    buffer_load_dwordx4 v[60:63], v124, s[64:67], s91 offen offset:2688
L_now:
    buffer_load_dwordx4 v[72:75], v125, s[48:51], s76 offen offset:512 nt
    buffer_load_dwordx4 v[76:79], v125, s[48:51], s76 offen offset:768 nt
    s_cmp_eq_u32 s10, 3
    s_cbranch_scc1 L_ldgate
L_sm:
    s_nop 1
    v_permlane32_swap_b32 v100, v104
    v_permlane32_swap_b32 v101, v105
    v_permlane32_swap_b32 v102, v106
    v_permlane32_swap_b32 v103, v107
    v_permlane32_swap_b32 v108, v112
    v_permlane32_swap_b32 v109, v113
    v_permlane32_swap_b32 v110, v114
    v_permlane32_swap_b32 v111, v115
    v_add_f32_dpp v100, v104, v100 row_ror:8 row_mask:0xf bank_mask:0xf
    v_add_f32_dpp v101, v105, v101 row_ror:8 row_mask:0xf bank_mask:0xf
    v_add_f32_dpp v102, v106, v102 row_ror:8 row_mask:0xf bank_mask:0xf
    v_add_f32_dpp v103, v107, v103 row_ror:8 row_mask:0xf bank_mask:0xf
    v_add_f32_dpp v104, v112, v108 row_ror:8 row_mask:0xf bank_mask:0xf
    v_add_f32_dpp v105, v113, v109 row_ror:8 row_mask:0xf bank_mask:0xf
    v_add_f32_dpp v106, v114, v110 row_ror:8 row_mask:0xf bank_mask:0xf
    v_add_f32_dpp v107, v115, v111 row_ror:8 row_mask:0xf bank_mask:0xf
    v_cvt_pk_bf16_f32 v116, v100, v101
    v_cvt_pk_bf16_f32 v117, v102, v103
    v_cvt_pk_bf16_f32 v118, v104, v105
    v_cvt_pk_bf16_f32 v119, v106, v107
    v_mov_b32_dpp v116, v116 row_ror:8 row_mask:0xf bank_mask:0xc
    v_mov_b32_dpp v117, v117 row_ror:8 row_mask:0xf bank_mask:0xc
    v_mov_b32_dpp v118, v118 row_ror:8 row_mask:0xf bank_mask:0xc
    v_mov_b32_dpp v119, v119 row_ror:8 row_mask:0xf bank_mask:0xc
    v_lshlrev_b32 v100, 16, v116
    v_and_b32 v101, s79, v116
    v_lshlrev_b32 v102, 16, v117
    v_and_b32 v103, s79, v117
    v_lshlrev_b32 v104, 16, v118
    v_and_b32 v105, s79, v118
    v_lshlrev_b32 v106, 16, v119
    v_and_b32 v107, s79, v119
    v_max3_f32 v116, v100, v101, v102
    v_max3_f32 v117, v103, v104, v105
    v_max3_f32 v116, v116, v106, v107
    v_max_f32 v116, v116, v117
    v_mov_b32 v117, v116
    s_nop 1
    v_permlane16_swap_b32 v116, v117
    v_max_f32 v116, v116, v117
    v_mov_b32 v117, v116
    s_nop 1
    v_permlane32_swap_b32 v116, v117
    v_max_f32 v116, v116, v117
    v_mul_f32 v119, s78, v116
    v_fma_f32 v100, v100, s78, -v119
    v_fma_f32 v101, v101, s78, -v119
    v_fma_f32 v102, v102, s78, -v119
    v_fma_f32 v103, v103, s78, -v119
    v_fma_f32 v104, v104, s78, -v119
    v_fma_f32 v105, v105, s78, -v119
    v_fma_f32 v106, v106, s78, -v119
    v_fma_f32 v107, v107, s78, -v119
    v_exp_f32 v100, v100
    v_exp_f32 v101, v101
    v_exp_f32 v102, v102
    v_exp_f32 v103, v103
    v_exp_f32 v104, v104
    v_exp_f32 v105, v105
    v_exp_f32 v106, v106
    v_exp_f32 v107, v107
    v_add_f32 v118, v100, v101
    v_add_f32 v117, v102, v103
    v_add_f32 v118, v118, v104
    v_add_f32 v117, v117, v105
    v_add_f32 v118, v118, v106
    v_add_f32 v117, v117, v107
    v_add_f32 v118, v118, v117
    v_mov_b32 v117, v118
    s_nop 1
    v_permlane16_swap_b32 v118, v117
    v_add_f32 v118, v118, v117
    v_mov_b32 v117, v118
    s_nop 1
    v_permlane32_swap_b32 v118, v117
    v_add_f32 v117, v118, v117
    s_lshl_b32 s11, s10, 3
    v_mov_b32 v127, s11
    ds_write_b64 v127, v[116:117] offset:512
    v_and_b32 v127, 15, v126
    v_lshlrev_b32 v127, 3, v127
    v_mov_b32 v118, 0
    s_waitcnt lgkmcnt(0)
    s_barrier
    ds_read_b64 v[112:113], v127 offset:512
    ds_read_b32 v124, v118 offset:776
    s_setprio 1
    buffer_load_dwordx4 v[80:83], v125, s[48:51], s76 offen offset:1024 nt
    buffer_load_dwordx4 v[84:87], v125, s[48:51], s76 offen offset:1280 nt
    buffer_load_dwordx4 v[88:91], v125, s[48:51], s76 offen offset:1536 nt
    buffer_load_dwordx4 v[92:95], v125, s[48:51], s76 offen offset:1792 nt
    s_waitcnt lgkmcnt(0)
    v_readfirstlane_b32 s92, v124
    v_mov_b32 v108, v112
    s_nop 1
    v_max_f32_dpp v108, v108, v108 row_ror:8 row_mask:0xf bank_mask:0xf
    s_nop 1
    v_max_f32_dpp v108, v108, v108 row_ror:4 row_mask:0xf bank_mask:0xf
    s_nop 1
    v_max_f32_dpp v108, v108, v108 row_ror:2 row_mask:0xf bank_mask:0xf
    s_nop 1
    v_max_f32_dpp v108, v108, v108 row_ror:1 row_mask:0xf bank_mask:0xf
    v_sub_f32 v116, v116, v108
    v_mul_f32 v116, s78, v116
    v_exp_f32 v116, v116
    s_cmp_eq_u32 s10, 2
    s_cbranch_scc1 L_stat
L_nostat:
    v_and_b32 v117, 8, v126
    v_cmp_ne_u32 vcc, 0, v117
    v_mov_b32 v117, s79
    s_nop 0
    v_cndmask_b32 v117, 0, v117, vcc
    v_mul_f32 v100, v100, v116
    v_mul_f32 v101, v101, v116
    v_mul_f32 v102, v102, v116
    v_mul_f32 v103, v103, v116
    v_mul_f32 v104, v104, v116
    v_mul_f32 v105, v105, v116
    v_mul_f32 v106, v106, v116
    v_mul_f32 v107, v107, v116
    v_cvt_pk_bf16_f32 v120, v100, v100
    v_and_b32 v120, v117, v120
    v_sub_f32 v100, v100, v120
    v_cvt_pk_bf16_f32 v100, v100, v100
    v_cvt_pk_bf16_f32 v121, v101, v101
    v_and_b32 v121, v117, v121
    v_sub_f32 v101, v101, v121
    v_cvt_pk_bf16_f32 v101, v101, v101
    v_cvt_pk_bf16_f32 v122, v102, v102
    v_and_b32 v122, v117, v122
    v_sub_f32 v102, v102, v122
    v_cvt_pk_bf16_f32 v102, v102, v102
    v_cvt_pk_bf16_f32 v123, v103, v103
    v_and_b32 v123, v117, v123
    v_sub_f32 v103, v103, v123
    v_cvt_pk_bf16_f32 v103, v103, v103
    v_cvt_pk_bf16_f32 v120, v104, v104
    v_and_b32 v120, v117, v120
    v_sub_f32 v104, v104, v120
    v_cvt_pk_bf16_f32 v104, v104, v104
    v_cvt_pk_bf16_f32 v121, v105, v105
    v_and_b32 v121, v117, v121
    v_sub_f32 v105, v105, v121
    v_cvt_pk_bf16_f32 v105, v105, v105
    v_cvt_pk_bf16_f32 v122, v106, v106
    v_and_b32 v122, v117, v122
    v_sub_f32 v106, v106, v122
    v_cvt_pk_bf16_f32 v106, v106, v106
    v_cvt_pk_bf16_f32 v123, v107, v107
    v_and_b32 v123, v117, v123
    v_sub_f32 v107, v107, v123
    v_cvt_pk_bf16_f32 v107, v107, v107
    s_cmp_eq_u32 s10, 2
    s_cbranch_scc1 L_gsync
L_gsync_ret:
    s_barrier
    buffer_load_dwordx4 v[0:3], v125, s[48:51], s77 offen offset:0 nt
    buffer_load_dwordx4 v[4:7], v125, s[48:51], s77 offen offset:256 nt
    buffer_load_dwordx4 v[8:11], v125, s[48:51], s77 offen offset:512 nt
    buffer_load_dwordx4 v[12:15], v125, s[48:51], s77 offen offset:768 nt
    buffer_load_dwordx4 v[16:19], v125, s[48:51], s77 offen offset:1024 nt
    buffer_load_dwordx4 v[20:23], v125, s[48:51], s77 offen offset:1280 nt
    buffer_load_dwordx4 v[24:27], v125, s[48:51], s77 offen offset:1536 nt
    buffer_load_dwordx4 v[28:31], v125, s[48:51], s77 offen offset:1792 nt
    v_and_b32 v116, v100, v96
    v_and_b32 v117, v100, v97
    v_and_b32 v118, v100, v98
    v_and_b32 v119, v100, v99
    s_waitcnt vmcnt(14)
    s_nop 0
    v_mfma_f32_16x16x32_bf16 v[108:111], v[116:119], v[64:67], 0
    v_mfma_f32_16x16x32_bf16 v[112:115], v[116:119], v[68:71], 0
    v_and_b32 v120, v101, v96
    v_and_b32 v121, v101, v97
    v_and_b32 v122, v101, v98
    v_and_b32 v123, v101, v99
    s_waitcnt vmcnt(12)
    s_nop 0
    v_mfma_f32_16x16x32_bf16 v[108:111], v[120:123], v[72:75], v[108:111]
    v_mfma_f32_16x16x32_bf16 v[112:115], v[120:123], v[76:79], v[112:115]
    v_and_b32 v116, v102, v96
    v_and_b32 v117, v102, v97
    v_and_b32 v118, v102, v98
    v_and_b32 v119, v102, v99
    s_waitcnt vmcnt(10)
    s_nop 0
    v_mfma_f32_16x16x32_bf16 v[108:111], v[116:119], v[80:83], v[108:111]
    v_mfma_f32_16x16x32_bf16 v[112:115], v[116:119], v[84:87], v[112:115]
    v_and_b32 v120, v103, v96
    v_and_b32 v121, v103, v97
    v_and_b32 v122, v103, v98
    v_and_b32 v123, v103, v99
    s_waitcnt vmcnt(8)
    s_nop 0
    v_mfma_f32_16x16x32_bf16 v[108:111], v[120:123], v[88:91], v[108:111]
    v_mfma_f32_16x16x32_bf16 v[112:115], v[120:123], v[92:95], v[112:115]
    v_and_b32 v64, v104, v96
    v_and_b32 v65, v104, v97
    v_and_b32 v66, v104, v98
    v_and_b32 v67, v104, v99
    v_and_b32 v68, v105, v96
    v_and_b32 v69, v105, v97
    v_and_b32 v70, v105, v98
    v_and_b32 v71, v105, v99
    v_and_b32 v72, v106, v96
    v_and_b32 v73, v106, v97
    v_and_b32 v74, v106, v98
    v_and_b32 v75, v106, v99
    v_and_b32 v76, v107, v96
    v_and_b32 v77, v107, v97
    v_and_b32 v78, v107, v98
    v_and_b32 v79, v107, v99
    v_lshrrev_b32 v116, 4, v126
    v_and_b32 v117, 15, v126
    s_lshl_b32 s11, s10, 10
    v_lshrrev_b32 v83, 5, v126
    v_lshlrev_b32 v83, 9, v83
    v_lshl_add_u32 v83, v117, 5, v83
    v_and_b32 v127, 16, v126
    v_add3_u32 v83, v83, v127, s11
    v_and_b32 v82, 31, v126
    v_lshlrev_b32 v82, 2, v82
    v_lshrrev_b32 v81, 5, v126
    v_lshl_add_u32 v81, v81, 13, v82
    s_and_b32 s12, s10, 7
    s_lshl_b32 s11, s12, 7
    v_add_u32 v81, s11, v81
    v_and_b32 v125, 3, v126
    v_add_u32 v125, 0x07060500, v125
    v_mov_b32 v80, 0
    s_lshl_b32 s82, s9, 3
    s_add_u32 s82, s82, s12
    s_lshl_b32 s82, s82, 3
    s_add_u32 s82, s82, s7
    s_lshl_b32 s82, s82, 7
    s_add_u32 s82, s82, 8192
    s_cmp_eq_u32 s85, 1
    s_cbranch_scc1 L_mid1
    s_cmp_eq_u32 s85, 2
    s_cbranch_scc1 L_mid2
    s_cmp_ge_u32 s10, 8
    s_cbranch_scc1 L_mid3
    s_cmp_eq_u32 s10, 3
    s_cbranch_scc1 L_gate
    s_cmp_eq_u32 s10, 1
    s_cbranch_scc1 L_ywarm
L_pv2:
    s_waitcnt vmcnt(6)
    v_mfma_f32_16x16x32_bf16 v[108:111], v[64:67], v[0:3], v[108:111]
    v_mfma_f32_16x16x32_bf16 v[112:115], v[64:67], v[4:7], v[112:115]
    s_waitcnt vmcnt(4)
    v_mfma_f32_16x16x32_bf16 v[108:111], v[68:71], v[8:11], v[108:111]
    v_mfma_f32_16x16x32_bf16 v[112:115], v[68:71], v[12:15], v[112:115]
    s_waitcnt vmcnt(2)
    v_mfma_f32_16x16x32_bf16 v[108:111], v[72:75], v[16:19], v[108:111]
    v_mfma_f32_16x16x32_bf16 v[112:115], v[72:75], v[20:23], v[112:115]
    s_waitcnt vmcnt(0)
    v_mfma_f32_16x16x32_bf16 v[108:111], v[76:79], v[24:27], v[108:111]
    v_mfma_f32_16x16x32_bf16 v[112:115], v[76:79], v[28:31], v[112:115]
    s_cmp_lt_u32 s10, 8
    s_nop 6
    v_permlane32_swap_b32 v108, v112
    v_permlane32_swap_b32 v109, v113
    v_permlane32_swap_b32 v110, v114
    v_permlane32_swap_b32 v111, v115
    v_add_f32 v108, v108, v112
    v_add_f32 v109, v109, v113
    v_add_f32 v110, v110, v114
    v_add_f32 v111, v111, v115
    ds_write_b128 v83, v[108:111] offset:5120
    s_cbranch_scc1 L_low
    s_setprio 3
    s_waitcnt lgkmcnt(0)
    s_barrier
    ds_read2st64_b32 v[0:1], v81 offset0:20 offset1:24
    ds_read2st64_b32 v[2:3], v81 offset0:28 offset1:32
    ds_read2st64_b32 v[4:5], v81 offset0:36 offset1:40
    ds_read2st64_b32 v[6:7], v81 offset0:44 offset1:48
    s_waitcnt lgkmcnt(2)
    v_add_f32 v0, v0, v1
    v_add_f32 v2, v2, v3
    s_waitcnt lgkmcnt(0)
    v_add_f32 v4, v4, v5
    v_add_f32 v6, v6, v7
    v_add_f32 v0, v0, v2
    v_add_f32 v4, v4, v6
    v_add_f32 v0, v0, v4
    v_mov_b32 v1, v0
    s_nop 1
    v_permlane32_swap_b32 v0, v1
    v_add_f32 v0, v0, v1
    v_perm_b32 v0, v0, v124, v125
    s_mov_b32 exec_hi, 0
    buffer_store_dword v0, v82, s[52:55], s82 offen sc1
    s_cmp_lt_u32 s86, 28
    s_cbranch_scc1 L_reduce
    s_endpgm
L_low:
    s_cmp_eq_u32 s85, 1
    s_cbranch_scc1 L_gemv1
    s_waitcnt lgkmcnt(0)
    s_barrier
    s_add_u32 s11, s86, s6
    s_add_u32 s11, s11, s10
    s_max_u32 s12, s86, 28
    s_cmp_lg_u32 s12, s86
    s_cselect_b32 s11, 99, s11
    s_cmp_eq_u32 s11, 28
    s_cbranch_scc1 L_epoch
    s_endpgm
L_gemv1:
    s_mov_b32 s87, 0
L_stchk:
    v_cmp_ne_u32 vcc, s92, v85
    v_cmp_ne_u32 s[80:81], s92, v87
    s_nop 0
    s_or_b64 vcc, vcc, s[80:81]
    s_cbranch_vccz L_stok
    s_add_u32 s87, s87, 1
    s_cmp_gt_u32 s87, 8388608
    s_cbranch_scc1 L_stok
    buffer_load_dwordx4 v[84:87], v89, s[52:55], s14 offen sc1
    s_waitcnt vmcnt(0)
    s_branch L_stchk
L_stok:
    v_mov_b32 v116, v84
    s_nop 1
    v_max_f32_dpp v116, v116, v116 quad_perm:[1,0,3,2] row_mask:0xf bank_mask:0xf
    s_nop 1
    v_max_f32_dpp v116, v116, v116 quad_perm:[2,3,0,1] row_mask:0xf bank_mask:0xf
    s_nop 1
    v_max_f32_dpp v116, v116, v116 row_half_mirror row_mask:0xf bank_mask:0xf
    v_sub_f32 v123, v84, v116
    v_mul_f32 v123, s78, v123
    v_exp_f32 v123, v123
    s_nop 0
    v_mul_f32 v116, v123, v86
    s_nop 1
    v_add_f32_dpp v116, v116, v116 quad_perm:[1,0,3,2] row_mask:0xf bank_mask:0xf
    s_nop 1
    v_add_f32_dpp v116, v116, v116 quad_perm:[2,3,0,1] row_mask:0xf bank_mask:0xf
    s_nop 1
    v_add_f32_dpp v116, v116, v116 row_half_mirror row_mask:0xf bank_mask:0xf
    v_rcp_f32 v116, v116
    s_nop 0
    v_mul_f32 v123, v123, v116
    s_mov_b32 s87, 0
    s_cmp_eq_u32 s63, 0
    s_setprio 0
    buffer_load_dwordx4 v[32:35], v121, s[64:67], 0 offen offset:0
    buffer_load_dwordx4 v[36:39], v121, s[64:67], 0 offen offset:896
    buffer_load_dwordx4 v[40:43], v121, s[64:67], 0 offen offset:1792
    buffer_load_dwordx4 v[44:47], v121, s[64:67], 0 offen offset:2688
    buffer_load_dwordx4 v[48:51], v121, s[64:67], s91 offen offset:0
    buffer_load_dwordx4 v[52:55], v121, s[64:67], s91 offen offset:896
    buffer_load_dwordx4 v[56:59], v121, s[64:67], s91 offen offset:1792
    buffer_load_dwordx4 v[60:63], v121, s[64:67], s91 offen offset:2688
    s_setprio 2
    s_waitcnt lgkmcnt(0)
    s_barrier
    buffer_load_dwordx4 v[0:3], v122, s[52:55], s83 offen sc1
    ds_read_b64 v[90:91], v80 offset:768
    s_cbranch_scc1 L_nof
    ds_read_b128 v[92:95], v120 offset:1024
L_nof:
    s_waitcnt lgkmcnt(0)
    v_mul_f32 v92, v92, v91
    v_mul_f32 v93, v93, v91
    v_mul_f32 v94, v94, v91
    v_mul_f32 v95, v95, v91
    s_waitcnt vmcnt(0)
L_ochk:
    v_perm_b32 v4, v1, v0, s3
    v_perm_b32 v5, v3, v2, s4
    v_or_b32 v4, v4, v5
    v_cmp_ne_u32 vcc, s92, v4
    s_nop 0
    s_cbranch_vccz L_ook
    s_mov_b64 exec, vcc
    buffer_load_dwordx4 v[0:3], v122, s[52:55], s83 offen sc1
    s_mov_b64 exec, -1
    s_add_u32 s87, s87, 1
    s_waitcnt vmcnt(0)
    s_cmp_gt_u32 s87, 8388608
    s_cbranch_scc0 L_ochk
L_ook:
    v_and_b32 v24, s94, v0
    v_and_b32 v25, s94, v1
    v_and_b32 v26, s94, v2
    v_and_b32 v27, s94, v3
    v_mul_f32 v24, v24, v123
    v_mul_f32 v25, v25, v123
    v_mul_f32 v26, v26, v123
    v_mul_f32 v27, v27, v123
    v_add_f32_dpp v24, v24, v24 quad_perm:[1,0,3,2] row_mask:0xf bank_mask:0xf
    v_add_f32_dpp v25, v25, v25 quad_perm:[1,0,3,2] row_mask:0xf bank_mask:0xf
    v_add_f32_dpp v26, v26, v26 quad_perm:[1,0,3,2] row_mask:0xf bank_mask:0xf
    v_add_f32_dpp v27, v27, v27 quad_perm:[1,0,3,2] row_mask:0xf bank_mask:0xf
    v_add_f32_dpp v24, v24, v24 quad_perm:[2,3,0,1] row_mask:0xf bank_mask:0xf
    v_add_f32_dpp v25, v25, v25 quad_perm:[2,3,0,1] row_mask:0xf bank_mask:0xf
    v_add_f32_dpp v26, v26, v26 quad_perm:[2,3,0,1] row_mask:0xf bank_mask:0xf
    v_add_f32_dpp v27, v27, v27 quad_perm:[2,3,0,1] row_mask:0xf bank_mask:0xf
    v_add_f32_dpp v24, v24, v24 row_half_mirror row_mask:0xf bank_mask:0xf
    v_add_f32_dpp v25, v25, v25 row_half_mirror row_mask:0xf bank_mask:0xf
    v_add_f32_dpp v26, v26, v26 row_half_mirror row_mask:0xf bank_mask:0xf
    v_add_f32_dpp v27, v27, v27 row_half_mirror row_mask:0xf bank_mask:0xf
    v_cvt_pk_bf16_f32 v24, v24, v24
    v_cvt_pk_bf16_f32 v25, v25, v25
    v_cvt_pk_bf16_f32 v26, v26, v26
    v_cvt_pk_bf16_f32 v27, v27, v27
    v_mov_b32_dpp v28, v24 row_ror:8 row_mask:0xf bank_mask:0xf
    v_mov_b32_dpp v29, v25 row_ror:8 row_mask:0xf bank_mask:0xf
    v_mov_b32_dpp v30, v26 row_ror:8 row_mask:0xf bank_mask:0xf
    v_mov_b32_dpp v31, v27 row_ror:8 row_mask:0xf bank_mask:0xf
    v_and_b32 v8, v24, v96
    v_and_b32 v9, v24, v97
    v_and_b32 v10, v24, v98
    v_and_b32 v11, v24, v99
    s_nop 1
    v_mfma_f32_16x16x32_bf16 v[108:111], v[8:11], v[32:35], 0
    v_and_b32 v12, v25, v96
    v_and_b32 v13, v25, v97
    v_and_b32 v14, v25, v98
    v_and_b32 v15, v25, v99
    s_nop 1
    v_mfma_f32_16x16x32_bf16 v[108:111], v[12:15], v[36:39], v[108:111]
    v_and_b32 v16, v26, v96
    v_and_b32 v17, v26, v97
    v_and_b32 v18, v26, v98
    v_and_b32 v19, v26, v99
    s_nop 1
    v_mfma_f32_16x16x32_bf16 v[108:111], v[16:19], v[40:43], v[108:111]
    v_and_b32 v20, v27, v96
    v_and_b32 v21, v27, v97
    v_and_b32 v22, v27, v98
    v_and_b32 v23, v27, v99
    s_nop 1
    v_mfma_f32_16x16x32_bf16 v[108:111], v[20:23], v[44:47], v[108:111]
    v_and_b32 v8, v28, v96
    v_and_b32 v9, v28, v97
    v_and_b32 v10, v28, v98
    v_and_b32 v11, v28, v99
    s_nop 1
    v_mfma_f32_16x16x32_bf16 v[108:111], v[8:11], v[48:51], v[108:111]
    v_and_b32 v12, v29, v96
    v_and_b32 v13, v29, v97
    v_and_b32 v14, v29, v98
    v_and_b32 v15, v29, v99
    s_nop 1
    v_mfma_f32_16x16x32_bf16 v[108:111], v[12:15], v[52:55], v[108:111]
    v_and_b32 v16, v30, v96
    v_and_b32 v17, v30, v97
    v_and_b32 v18, v30, v98
    v_and_b32 v19, v30, v99
    s_nop 1
    v_mfma_f32_16x16x32_bf16 v[108:111], v[16:19], v[56:59], v[108:111]
    v_and_b32 v20, v31, v96
    v_and_b32 v21, v31, v97
    v_and_b32 v22, v31, v98
    v_and_b32 v23, v31, v99
    s_nop 1
    v_mfma_f32_16x16x32_bf16 v[108:111], v[20:23], v[60:63], v[108:111]
    s_mov_b32 exec_hi, 0
    s_nop 6
    v_fma_f32 v108, v108, v90, v92
    v_fma_f32 v109, v109, v90, v93
    v_fma_f32 v110, v110, v90, v94
    v_fma_f32 v111, v111, v90, v95
    v_perm_b32 v108, v108, v124, s40
    v_perm_b32 v109, v109, v124, s41
    v_perm_b32 v110, v110, v124, s60
    v_perm_b32 v111, v111, v124, s61
    buffer_store_dwordx4 v[108:111], v88, s[52:55], s84 offen sc1
    s_cmp_ge_u32 s86, 28
    s_cbranch_scc1 L_end
    s_barrier
    s_endpgm
L_reduce:
    s_mov_b64 exec, -1
    s_setprio 0
    s_barrier
    buffer_load_dwordx4 v[8:11], v84, s[52:55], s83 offen sc1
    s_mov_b32 s87, 0
    s_waitcnt vmcnt(0)
L_ypoll:
    v_perm_b32 v4, v9, v8, s3
    v_perm_b32 v5, v11, v10, s4
    v_or_b32 v4, v4, v5
    v_cmp_ne_u32 vcc, s92, v4
    s_nop 0
    s_cbranch_vccz L_yok
    s_mov_b64 exec, vcc
    buffer_load_dwordx4 v[8:11], v84, s[52:55], s83 offen sc1
    s_mov_b64 exec, -1
    s_add_u32 s87, s87, 1
    s_waitcnt vmcnt(0)
    s_cmp_gt_u32 s87, 8388608
    s_cbranch_scc0 L_ypoll
L_yok:
    v_and_b32 v16, s94, v8
    v_and_b32 v17, s94, v9
    v_and_b32 v18, s94, v10
    v_and_b32 v19, s94, v11
    v_add_f32_dpp v16, v16, v16 row_ror:8 row_mask:0xf bank_mask:0xf
    v_add_f32_dpp v17, v17, v17 row_ror:8 row_mask:0xf bank_mask:0xf
    v_add_f32_dpp v18, v18, v18 row_ror:8 row_mask:0xf bank_mask:0xf
    v_add_f32_dpp v19, v19, v19 row_ror:8 row_mask:0xf bank_mask:0xf
    v_add_f32_dpp v16, v16, v16 row_ror:4 row_mask:0xf bank_mask:0xf
    v_add_f32_dpp v17, v17, v17 row_ror:4 row_mask:0xf bank_mask:0xf
    v_add_f32_dpp v18, v18, v18 row_ror:4 row_mask:0xf bank_mask:0xf
    v_add_f32_dpp v19, v19, v19 row_ror:4 row_mask:0xf bank_mask:0xf
    v_add_f32_dpp v16, v16, v16 row_ror:2 row_mask:0xf bank_mask:0xf
    v_add_f32_dpp v17, v17, v17 row_ror:2 row_mask:0xf bank_mask:0xf
    v_add_f32_dpp v18, v18, v18 row_ror:2 row_mask:0xf bank_mask:0xf
    v_add_f32_dpp v19, v19, v19 row_ror:2 row_mask:0xf bank_mask:0xf
    v_add_f32_dpp v16, v16, v16 row_ror:1 row_mask:0xf bank_mask:0xf
    v_add_f32_dpp v17, v17, v17 row_ror:1 row_mask:0xf bank_mask:0xf
    v_add_f32_dpp v18, v18, v18 row_ror:1 row_mask:0xf bank_mask:0xf
    v_add_f32_dpp v19, v19, v19 row_ror:1 row_mask:0xf bank_mask:0xf
    s_mov_b64 exec, s[80:81]
    ds_write_b128 v85, v[16:19] offset:21504
    s_mov_b64 exec, 1
    ds_add_rtn_u32 v4, v80, v86 offset:780
    s_mov_b64 exec, -1
    ds_read_b128 v[12:15], v84 offset:21504
    s_waitcnt lgkmcnt(1)
    v_readfirstlane_b32 s11, v4
    s_nop 0
    s_cmp_lg_u32 s11, 7
    s_cbranch_scc1 L_yend
    s_waitcnt lgkmcnt(0)
    v_add_f32_dpp v12, v12, v12 row_ror:8 row_mask:0xf bank_mask:0xf
    v_add_f32_dpp v13, v13, v13 row_ror:8 row_mask:0xf bank_mask:0xf
    v_add_f32_dpp v14, v14, v14 row_ror:8 row_mask:0xf bank_mask:0xf
    v_add_f32_dpp v15, v15, v15 row_ror:8 row_mask:0xf bank_mask:0xf
    v_add_f32_dpp v12, v12, v12 row_ror:4 row_mask:0xf bank_mask:0xf
    v_add_f32_dpp v13, v13, v13 row_ror:4 row_mask:0xf bank_mask:0xf
    v_add_f32_dpp v14, v14, v14 row_ror:4 row_mask:0xf bank_mask:0xf
    v_add_f32_dpp v15, v15, v15 row_ror:4 row_mask:0xf bank_mask:0xf
    v_add_f32_dpp v12, v12, v12 row_ror:2 row_mask:0xf bank_mask:0xf
    v_add_f32_dpp v13, v13, v13 row_ror:2 row_mask:0xf bank_mask:0xf
    v_add_f32_dpp v14, v14, v14 row_ror:2 row_mask:0xf bank_mask:0xf
    v_add_f32_dpp v15, v15, v15 row_ror:2 row_mask:0xf bank_mask:0xf
    v_add_f32_dpp v12, v12, v12 row_ror:1 row_mask:0xf bank_mask:0xf
    v_add_f32_dpp v13, v13, v13 row_ror:1 row_mask:0xf bank_mask:0xf
    v_add_f32_dpp v14, v14, v14 row_ror:1 row_mask:0xf bank_mask:0xf
    v_add_f32_dpp v15, v15, v15 row_ror:1 row_mask:0xf bank_mask:0xf
    v_cvt_pk_bf16_f32 v12, v12, v13
    v_cvt_pk_bf16_f32 v13, v14, v15
    s_mov_b64 exec, s[80:81]
    global_store_dwordx2 v90, v[12:13], s[38:39]
L_yend:
    s_endpgm
L_epoch:
    s_mov_b32 s87, 0
    v_lshlrev_b32 v84, 4, v126
    s_movk_i32 s14, 4096
L_fchk:
    buffer_load_dwordx4 v[32:35], v84, s[52:55], s14 offen offset:0 sc1
    buffer_load_dwordx4 v[36:39], v84, s[52:55], s14 offen offset:1024 sc1
    buffer_load_dwordx4 v[40:43], v84, s[52:55], s14 offen offset:2048 sc1
    buffer_load_dwordx4 v[44:47], v84, s[52:55], s14 offen offset:3072 sc1
    s_waitcnt vmcnt(0)
    v_xor_b32 v33, s92, v33
    v_xor_b32 v37, s92, v37
    v_xor_b32 v41, s92, v41
    v_xor_b32 v45, s92, v45
    v_or3_b32 v33, v33, v37, v41
    v_or_b32 v33, v33, v45
    v_cmp_ne_u32 vcc, 0, v33
    s_nop 0
    s_cbranch_vccz L_fok
    s_add_u32 s87, s87, 1
    s_cmp_gt_u32 s87, 8388608
    s_cbranch_scc0 L_fchk
L_fok:
    s_mov_b64 exec, 1
    buffer_store_dword v124, off, s[52:55], 0 offset:0 sc1
    s_endpgm
L_stat:
    v_sub_f32 v112, v112, v108
    v_mul_f32 v112, s78, v112
    v_exp_f32 v112, v112
    s_nop 0
    v_mul_f32 v110, v113, v112
    s_nop 1
    v_add_f32_dpp v110, v110, v110 row_ror:8 row_mask:0xf bank_mask:0xf
    s_nop 1
    v_add_f32_dpp v110, v110, v110 row_ror:4 row_mask:0xf bank_mask:0xf
    s_nop 1
    v_add_f32_dpp v110, v110, v110 row_ror:2 row_mask:0xf bank_mask:0xf
    s_nop 1
    v_add_f32_dpp v110, v110, v110 row_ror:1 row_mask:0xf bank_mask:0xf
    v_mov_b32 v109, s92
    v_mov_b32 v111, s92
    s_lshl_b32 s11, s9, 3
    s_add_u32 s11, s11, s7
    s_lshl_b32 s11, s11, 4
    s_add_u32 s11, s11, 4096
    s_mov_b64 exec, 1
    buffer_store_dwordx4 v[108:111], off, s[52:55], s11 sc1
    s_mov_b64 exec, -1
    s_branch L_nostat
L_gsync:
    v_lshlrev_b32 v36, 4, v126
    s_lshl_b32 s14, s9, 7
    s_andn2_b32 s14, s14, 127
    s_add_u32 s14, s14, 4096
    s_mov_b32 s87, 0
    s_mov_b32 exec_lo, 0xff
    s_mov_b32 exec_hi, 0
L_gs:
    buffer_load_dword v37, v36, s[52:55], s14 offen offset:4 sc1
    s_waitcnt vmcnt(0)
    v_cmp_ne_u32 vcc, s92, v37
    s_nop 0
    s_cbranch_vccz L_gs_ok
    s_add_u32 s87, s87, 1
    s_cmp_gt_u32 s87, 8388608
    s_cbranch_scc0 L_gs
L_gs_ok:
    s_mov_b64 exec, -1
    s_branch L_gsync_ret
L_mid1:
    v_and_b32 v127, 7, v126
    v_lshlrev_b32 v89, 4, v127
    s_lshl_b32 s14, s9, 7
    s_add_u32 s14, s14, 4096
    v_lshlrev_b32 v122, 7, v127
    v_lshl_add_u32 v122, v116, 5, v122
    v_bfe_u32 v127, v126, 3, 1
    v_lshl_add_u32 v122, v127, 4, v122
    s_lshl_b32 s83, s9, 3
    s_add_u32 s83, s83, s7
    s_lshl_b32 s83, s83, 10
    s_add_u32 s83, s83, 8192
    buffer_load_dwordx4 v[84:87], v89, s[52:55], s14 offen sc1
    s_and_b32 s11, s10, 3
    s_cmp_lg_u32 s11, 0
    s_cbranch_scc1 L_mid1b
    buffer_load_dwordx4 v[100:103], v122, s[52:55], s83 offen sc1
L_mid1b:
    s_lshl_b32 s12, s11, 10
    v_lshlrev_b32 v120, 4, v126
    v_add_u32 v120, s12, v120
    v_lshrrev_b32 v88, 1, v117
    v_mul_u32_u24 v88, 8448, v88
    v_and_b32 v127, 1, v117
    v_lshl_add_u32 v88, v127, 5, v88
    v_and_b32 v127, 16, v126
    v_add_u32 v88, v88, v127
    s_mul_i32 s84, s6, 28
    s_lshl_b32 s12, s11, 3
    s_add_u32 s84, s84, s12
    s_mul_i32 s84, s84, 8448
    s_lshl_b32 s12, s5, 3
    s_add_u32 s12, s12, s7
    s_lshl_b32 s12, s12, 6
    s_add_u32 s84, s84, s12
    s_add_u32 s84, s84, 794624
    s_cmp_eq_u32 s11, 3
    s_cselect_b32 s11, 8, 0
    v_and_b32 v127, s11, v126
    v_lshl_or_b32 v88, v127, 27, v88
    v_mul_u32_u24 v121, 7168, v116
    v_lshl_add_u32 v121, v117, 4, v121
    v_lshl_or_b32 v121, v127, 27, v121
    s_and_b32 s11, s10, 3
    s_lshl_b32 s11, s11, 8
    v_add_u32 v121, s11, v121
    v_mov_b32 v92, 0
    v_mov_b32 v93, 0
    v_mov_b32 v94, 0
    v_mov_b32 v95, 0
    s_branch L_pv2
L_mid2:
    v_lshlrev_b32 v127, 5, v116
    ds_read_b128 v[84:87], v127 offset:640
    ds_read_b128 v[88:91], v127 offset:656
    s_waitcnt lgkmcnt(0)
    v_cvt_pk_bf16_f32 v84, v84, v84
    v_cvt_pk_bf16_f32 v85, v85, v85
    v_cvt_pk_bf16_f32 v86, v86, v86
    v_cvt_pk_bf16_f32 v87, v87, v87
    v_cvt_pk_bf16_f32 v88, v88, v88
    v_cvt_pk_bf16_f32 v89, v89, v89
    v_cvt_pk_bf16_f32 v90, v90, v90
    v_cvt_pk_bf16_f32 v91, v91, v91
    v_and_b32 v116, v84, v96
    v_and_b32 v117, v84, v97
    v_and_b32 v118, v84, v98
    v_and_b32 v119, v84, v99
    s_nop 1
    v_mfma_f32_16x16x32_bf16 v[92:95], v[116:119], v[32:35], 0
    v_and_b32 v120, v85, v96
    v_and_b32 v121, v85, v97
    v_and_b32 v122, v85, v98
    v_and_b32 v123, v85, v99
    s_nop 1
    v_mfma_f32_16x16x32_bf16 v[92:95], v[120:123], v[36:39], v[92:95]
    v_and_b32 v116, v86, v96
    v_and_b32 v117, v86, v97
    v_and_b32 v118, v86, v98
    v_and_b32 v119, v86, v99
    s_nop 1
    v_mfma_f32_16x16x32_bf16 v[92:95], v[116:119], v[40:43], v[92:95]
    v_and_b32 v120, v87, v96
    v_and_b32 v121, v87, v97
    v_and_b32 v122, v87, v98
    v_and_b32 v123, v87, v99
    s_nop 1
    v_mfma_f32_16x16x32_bf16 v[92:95], v[120:123], v[44:47], v[92:95]
    v_and_b32 v116, v88, v96
    v_and_b32 v117, v88, v97
    v_and_b32 v118, v88, v98
    v_and_b32 v119, v88, v99
    s_nop 1
    v_mfma_f32_16x16x32_bf16 v[92:95], v[116:119], v[48:51], v[92:95]
    v_and_b32 v120, v89, v96
    v_and_b32 v121, v89, v97
    v_and_b32 v122, v89, v98
    v_and_b32 v123, v89, v99
    s_nop 1
    v_mfma_f32_16x16x32_bf16 v[92:95], v[120:123], v[52:55], v[92:95]
    v_and_b32 v116, v90, v96
    v_and_b32 v117, v90, v97
    v_and_b32 v118, v90, v98
    v_and_b32 v119, v90, v99
    s_nop 1
    v_mfma_f32_16x16x32_bf16 v[92:95], v[116:119], v[56:59], v[92:95]
    v_and_b32 v120, v91, v96
    v_and_b32 v121, v91, v97
    v_and_b32 v122, v91, v98
    v_and_b32 v123, v91, v99
    s_nop 1
    v_mfma_f32_16x16x32_bf16 v[92:95], v[120:123], v[60:63], v[92:95]
    s_and_b32 s11, s10, 3
    s_lshl_b32 s12, s11, 10
    v_lshlrev_b32 v127, 4, v126
    v_add_u32 v127, s12, v127
    s_nop 3
    ds_write_b128 v127, v[92:95] offset:1024
    v_lshrrev_b32 v116, 4, v126
    v_and_b32 v117, 15, v126
L_mid3:
    s_cmp_ge_u32 s86, 28
    s_cbranch_scc1 L_pv2
    v_lshlrev_b32 v84, 6, v117
    v_lshl_add_u32 v84, v116, 4, v84
    s_mov_b32 s80, 0x00010001
    s_mov_b32 s81, 0x00010001
    s_and_b32 s12, s10, 7
    s_lshl_b32 s11, s12, 6
    v_lshlrev_b32 v85, 4, v116
    v_add_u32 v85, s11, v85
    v_mov_b32 v86, 1
    s_lshl_b32 s11, s86, 5
    s_mul_i32 s13, s6, 896
    s_add_u32 s11, s11, s13
    v_lshlrev_b32 v90, 3, v116
    v_add_u32 v90, s11, v90
    s_mul_i32 s83, s6, 28
    s_add_u32 s83, s83, s86
    s_mul_i32 s83, s83, 8448
    s_lshl_b32 s12, s12, 10
    s_add_u32 s83, s83, s12
    s_add_u32 s83, s83, 794624
    s_branch L_pv2
L_ywarm:
    s_cmp_ge_u32 s86, 28
    s_cbranch_scc1 L_pv2
    s_mul_i32 s83, s6, 28
    s_add_u32 s83, s83, s86
    s_mul_i32 s83, s83, 8448
    s_add_u32 s83, s83, 794624
    v_lshlrev_b32 v84, 7, v126
    buffer_load_dword v32, v84, s[52:55], s83 offen sc1
    s_branch L_pv2
L_gate:
    v_mov_b32 v44, 0
    v_lshlrev_b32 v40, 16, v32
    v_and_b32 v41, s79, v32
    v_lshlrev_b32 v42, 16, v36
    v_and_b32 v43, s79, v36
    v_mul_f32 v40, v40, v42
    v_mul_f32 v41, v41, v43
    v_cvt_pk_bf16_f32 v40, v40, v41
    v_lshlrev_b32 v41, 16, v40
    v_and_b32 v40, s79, v40
    v_add_f32 v44, v44, v41
    v_add_f32 v44, v44, v40
    v_lshlrev_b32 v40, 16, v33
    v_and_b32 v41, s79, v33
    v_lshlrev_b32 v42, 16, v37
    v_and_b32 v43, s79, v37
    v_mul_f32 v40, v40, v42
    v_mul_f32 v41, v41, v43
    v_cvt_pk_bf16_f32 v40, v40, v41
    v_lshlrev_b32 v41, 16, v40
    v_and_b32 v40, s79, v40
    v_add_f32 v44, v44, v41
    v_add_f32 v44, v44, v40
    v_lshlrev_b32 v40, 16, v34
    v_and_b32 v41, s79, v34
    v_lshlrev_b32 v42, 16, v38
    v_and_b32 v43, s79, v38
    v_mul_f32 v40, v40, v42
    v_mul_f32 v41, v41, v43
    v_cvt_pk_bf16_f32 v40, v40, v41
    v_lshlrev_b32 v41, 16, v40
    v_and_b32 v40, s79, v40
    v_add_f32 v44, v44, v41
    v_add_f32 v44, v44, v40
    v_lshlrev_b32 v40, 16, v35
    v_and_b32 v41, s79, v35
    v_lshlrev_b32 v42, 16, v39
    v_and_b32 v43, s79, v39
    v_mul_f32 v40, v40, v42
    v_mul_f32 v41, v41, v43
    v_cvt_pk_bf16_f32 v40, v40, v41
    v_lshlrev_b32 v41, 16, v40
    v_and_b32 v40, s79, v40
    v_add_f32 v44, v44, v41
    v_add_f32 v44, v44, v40
    s_nop 1
    v_add_f32_dpp v44, v44, v44 row_ror:8 row_mask:0xf bank_mask:0xf
    s_nop 1
    v_add_f32_dpp v44, v44, v44 row_ror:4 row_mask:0xf bank_mask:0xf
    s_nop 1
    v_add_f32_dpp v44, v44, v44 row_ror:2 row_mask:0xf bank_mask:0xf
    s_nop 1
    v_add_f32_dpp v44, v44, v44 row_ror:1 row_mask:0xf bank_mask:0xf
    v_mov_b32 v45, v44
    s_nop 1
    v_permlane16_swap_b32 v44, v45
    v_add_f32 v44, v44, v45
    v_mov_b32 v45, v44
    s_nop 1
    v_permlane32_swap_b32 v44, v45
    v_add_f32 v44, v44, v45
    v_cvt_pk_bf16_f32 v44, v44, v44
    v_and_b32 v44, s79, v44
    v_mul_f32 v44, 0xbfb8aa3b, v44
    v_exp_f32 v44, v44
    s_nop 0
    v_add_f32 v44, 1.0, v44
    v_rcp_f32 v44, v44
    s_nop 0
    v_cvt_pk_bf16_f32 v44, v44, v44
    v_and_b32 v44, s79, v44
    v_sub_f32 v45, 1.0, v44
    v_cvt_pk_bf16_f32 v45, v45, v45
    v_and_b32 v45, s79, v45
    ds_write_b64 v80, v[44:45] offset:768
    s_cmp_ge_u32 s86, 28
    s_cbranch_scc1 L_pv2
    v_lshlrev_b32 v40, 16, v46
    v_and_b32 v41, s79, v46
    v_lshlrev_b32 v42, 16, v47
    v_and_b32 v43, s79, v47
    v_mul_f32 v40, v40, v45
    v_mul_f32 v41, v41, v45
    v_mul_f32 v42, v42, v45
    v_mul_f32 v43, v43, v45
    v_lshlrev_b32 v127, 4, v116
    ds_write_b128 v127, v[40:43] offset:22016
    s_branch L_pv2
L_ldgate:
    v_mov_b32 v32, 0
    v_mov_b32 v33, 0
    v_mov_b32 v34, 0
    v_mov_b32 v35, 0
    v_mov_b32 v36, 0
    v_mov_b32 v37, 0
    v_mov_b32 v38, 0
    v_mov_b32 v39, 0
    v_lshlrev_b32 v117, 4, v126
    s_mul_i32 s11, s6, 896
    v_add_u32 v116, s11, v117
    s_min_u32 s11, s86, 27
    s_lshl_b32 s11, s11, 5
    v_lshrrev_b32 v118, 4, v126
    v_lshlrev_b32 v118, 3, v118
    v_add_u32 v118, s11, v118
    s_mov_b32 exec_hi, 0x00ffffff
    global_load_dwordx4 v[32:35], v116, s[16:17]
    global_load_dwordx4 v[36:39], v117, s[36:37]
    s_mov_b64 exec, -1
    global_load_dwordx2 v[46:47], v118, s[34:35]
    s_branch L_sm
L_stage1:
    s_movk_i32 s83, 3584
    s_mov_b32 s82, 532480
    s_lshr_b32 s11, s8, 1
    s_and_b32 s11, s11, 1
    s_and_b32 s12, s8, 3
    s_cmp_eq_u32 s10, 0
    s_cselect_b32 s83, 8192, s83
    s_cselect_b32 s84, 9, 8
    s_cselect_b32 s13, s5, s93
    s_cselect_b32 s82, 270336, s82
    s_cselect_b32 s14, s12, s11
    s_mul_i32 s87, s83, 448
    s_lshl_b32 s13, s13, s84
    s_lshr_b32 s12, s8, 2
    s_mul_i32 s11, s12, 112
    s_mul_i32 s11, s11, s83
    s_add_u32 s13, s13, s11
    s_lshl_b32 s11, s14, 7
    s_add_u32 s13, s13, s11
    s_sub_u32 s58, s87, s13
    s_mul_i32 s11, s83, 14
    v_lshrrev_b32 v102, 3, v126
    v_mul_u32_u24 v127, s11, v102
    v_and_b32 v103, 7, v126
    v_lshl_add_u32 v127, v103, 4, v127
    s_mov_b32 s60, s83
    s_add_u32 s61, s60, s83
    s_add_u32 s62, s61, s83
    s_add_u32 s64, s62, s83
    s_add_u32 s65, s64, s83
    s_add_u32 s66, s65, s83
    s_add_u32 s67, s66, s83
    s_add_u32 s69, s67, s83
    s_add_u32 s70, s69, s83
    s_add_u32 s71, s70, s83
    s_add_u32 s76, s71, s83
    s_add_u32 s77, s76, s83
    s_add_u32 s78, s77, s83
    v_mul_u32_u24 v100, 28, v102
    s_mul_i32 s11, s12, 224
    v_add_u32 v100, s11, v100
    v_mov_b32 v101, 0
    s_cmp_eq_u32 s10, 0
    s_waitcnt lgkmcnt(0)
    s_cselect_b32 s56, s22, s28
    s_cselect_b32 s57, s23, s29
    s_add_u32 s56, s56, s13
    s_addc_u32 s57, s57, 0
    buffer_load_dwordx4 v[0:3], v127, s[56:59], 0 offen
    buffer_load_dwordx4 v[4:7], v127, s[56:59], s60 offen
    buffer_load_dwordx4 v[8:11], v127, s[56:59], s61 offen
    buffer_load_dwordx4 v[12:15], v127, s[56:59], s62 offen
    buffer_load_dwordx4 v[16:19], v127, s[56:59], s64 offen
    buffer_load_dwordx4 v[20:23], v127, s[56:59], s65 offen
    buffer_load_dwordx4 v[24:27], v127, s[56:59], s66 offen
    buffer_load_dwordx4 v[28:31], v127, s[56:59], s67 offen
    buffer_load_dwordx4 v[32:35], v127, s[56:59], s69 offen
    buffer_load_dwordx4 v[36:39], v127, s[56:59], s70 offen
    buffer_load_dwordx4 v[40:43], v127, s[56:59], s71 offen
    buffer_load_dwordx4 v[44:47], v127, s[56:59], s76 offen
    buffer_load_dwordx4 v[48:51], v127, s[56:59], s77 offen
    buffer_load_dwordx4 v[52:55], v127, s[56:59], s78 offen
    global_load_dwordx4 v[56:59], v100, s[16:17]
    global_load_dwordx3 v[60:62], v100, s[16:17] offset:16
    global_load_dwordx4 v[64:67], v100, s[16:17] offset:896
    global_load_dwordx3 v[68:70], v100, s[16:17] offset:912
    global_load_dword v63, v101, s[42:43] offset:0 sc1
    s_add_u32 s44, s18, s68
    s_addc_u32 s45, s19, 0
    s_add_u32 s48, s20, s68
    s_addc_u32 s49, s21, 0
    s_mov_b32 s52, s42
    s_mov_b32 s53, s43
    v_and_b32 v100, 1, v126
    v_lshlrev_b32 v100, 4, v100
    v_mov_b32 v101, 0xffff
    v_lshlrev_b32 v101, v100, v101
    v_bfe_u32 v102, v126, 1, 2
    v_cmp_eq_u32 vcc, 0, v102
    s_mov_b32 s40, 117835008
    s_nop 0
    v_cndmask_b32 v96, 0, v101, vcc
    v_cmp_eq_u32 vcc, 1, v102
    s_mov_b32 s41, 117835009
    s_nop 0
    v_cndmask_b32 v97, 0, v101, vcc
    v_cmp_eq_u32 vcc, 2, v102
    s_mov_b32 s60, 117835010
    s_nop 0
    v_cndmask_b32 v98, 0, v101, vcc
    v_cmp_eq_u32 vcc, 3, v102
    s_mov_b32 s61, 117835011
    s_nop 0
    v_cndmask_b32 v99, 0, v101, vcc
    s_mov_b32 s3, 0x0c0c0400
    s_mov_b32 s4, 0x04000c0c
    s_movk_i32 s94, 0xff00
    v_lshrrev_b32 v127, 1, v121
    v_lshlrev_b32 v127, 12, v127
    v_lshl_add_u32 v127, v120, 5, v127
    v_and_b32 v100, 16, v126
    v_add_u32 v127, v127, v100
    s_lshl_b32 s11, s5, 13
    s_add_u32 s82, s82, s11
    s_lshl_b32 s11, s6, 12
    s_add_u32 s83, s82, s11
    s_lshl_b32 s13, s12, 10
    s_add_u32 s82, s82, s13
    s_lshl_b32 s13, s14, 8
    s_add_u32 s82, s82, s13
    s_mov_b32 s13, 0x01000100
    s_mov_b32 s14, 0x03020302
    v_lshlrev_b32 v109, 4, v126
    s_waitcnt vmcnt(0)
    v_and_b32 v108, 0x7f7f7f7f, v63
    v_add_u32 v108, 0x671b3501, v108
    v_xor_b32 v63, 0xe79b3501, v63
    v_and_b32 v63, 0x80808080, v63
    v_xor_b32 v108, v108, v63
    v_mov_b32 v63, 0
    v_readfirstlane_b32 s92, v108
    ds_write_b32 v63, v108 offset:776
    v_perm_b32 v110, v56, v56, s13
    v_and_b32 v116, v110, v96
    v_and_b32 v117, v110, v97
    v_and_b32 v118, v110, v98
    v_and_b32 v119, v110, v99
    s_nop 1
    v_mfma_f32_16x16x32_bf16 v[100:103], v[116:119], v[0:3], 0
    v_perm_b32 v111, v64, v64, s13
    v_and_b32 v112, v111, v96
    v_and_b32 v113, v111, v97
    v_and_b32 v114, v111, v98
    v_and_b32 v115, v111, v99
    s_nop 1
    v_mfma_f32_16x16x32_bf16 v[104:107], v[112:115], v[0:3], 0
    v_perm_b32 v110, v56, v56, s14
    v_and_b32 v116, v110, v96
    v_and_b32 v117, v110, v97
    v_and_b32 v118, v110, v98
    v_and_b32 v119, v110, v99
    s_nop 1
    v_mfma_f32_16x16x32_bf16 v[100:103], v[116:119], v[4:7], v[100:103]
    v_perm_b32 v111, v64, v64, s14
    v_and_b32 v112, v111, v96
    v_and_b32 v113, v111, v97
    v_and_b32 v114, v111, v98
    v_and_b32 v115, v111, v99
    s_nop 1
    v_mfma_f32_16x16x32_bf16 v[104:107], v[112:115], v[4:7], v[104:107]
    v_perm_b32 v110, v57, v57, s13
    v_and_b32 v116, v110, v96
    v_and_b32 v117, v110, v97
    v_and_b32 v118, v110, v98
    v_and_b32 v119, v110, v99
    s_nop 1
    v_mfma_f32_16x16x32_bf16 v[100:103], v[116:119], v[8:11], v[100:103]
    v_perm_b32 v111, v65, v65, s13
    v_and_b32 v112, v111, v96
    v_and_b32 v113, v111, v97
    v_and_b32 v114, v111, v98
    v_and_b32 v115, v111, v99
    s_nop 1
    v_mfma_f32_16x16x32_bf16 v[104:107], v[112:115], v[8:11], v[104:107]
    v_perm_b32 v110, v57, v57, s14
    v_and_b32 v116, v110, v96
    v_and_b32 v117, v110, v97
    v_and_b32 v118, v110, v98
    v_and_b32 v119, v110, v99
    s_nop 1
    v_mfma_f32_16x16x32_bf16 v[100:103], v[116:119], v[12:15], v[100:103]
    v_perm_b32 v111, v65, v65, s14
    v_and_b32 v112, v111, v96
    v_and_b32 v113, v111, v97
    v_and_b32 v114, v111, v98
    v_and_b32 v115, v111, v99
    s_nop 1
    v_mfma_f32_16x16x32_bf16 v[104:107], v[112:115], v[12:15], v[104:107]
    v_perm_b32 v110, v58, v58, s13
    v_and_b32 v116, v110, v96
    v_and_b32 v117, v110, v97
    v_and_b32 v118, v110, v98
    v_and_b32 v119, v110, v99
    s_nop 1
    v_mfma_f32_16x16x32_bf16 v[100:103], v[116:119], v[16:19], v[100:103]
    v_perm_b32 v111, v66, v66, s13
    v_and_b32 v112, v111, v96
    v_and_b32 v113, v111, v97
    v_and_b32 v114, v111, v98
    v_and_b32 v115, v111, v99
    s_nop 1
    v_mfma_f32_16x16x32_bf16 v[104:107], v[112:115], v[16:19], v[104:107]
    v_perm_b32 v110, v58, v58, s14
    v_and_b32 v116, v110, v96
    v_and_b32 v117, v110, v97
    v_and_b32 v118, v110, v98
    v_and_b32 v119, v110, v99
    s_nop 1
    v_mfma_f32_16x16x32_bf16 v[100:103], v[116:119], v[20:23], v[100:103]
    v_perm_b32 v111, v66, v66, s14
    v_and_b32 v112, v111, v96
    v_and_b32 v113, v111, v97
    v_and_b32 v114, v111, v98
    v_and_b32 v115, v111, v99
    s_nop 1
    v_mfma_f32_16x16x32_bf16 v[104:107], v[112:115], v[20:23], v[104:107]
    v_perm_b32 v110, v59, v59, s13
    v_and_b32 v116, v110, v96
    v_and_b32 v117, v110, v97
    v_and_b32 v118, v110, v98
    v_and_b32 v119, v110, v99
    s_nop 1
    v_mfma_f32_16x16x32_bf16 v[100:103], v[116:119], v[24:27], v[100:103]
    v_perm_b32 v111, v67, v67, s13
    v_and_b32 v112, v111, v96
    v_and_b32 v113, v111, v97
    v_and_b32 v114, v111, v98
    v_and_b32 v115, v111, v99
    s_nop 1
    v_mfma_f32_16x16x32_bf16 v[104:107], v[112:115], v[24:27], v[104:107]
    v_perm_b32 v110, v59, v59, s14
    v_and_b32 v116, v110, v96
    v_and_b32 v117, v110, v97
    v_and_b32 v118, v110, v98
    v_and_b32 v119, v110, v99
    s_nop 1
    v_mfma_f32_16x16x32_bf16 v[100:103], v[116:119], v[28:31], v[100:103]
    v_perm_b32 v111, v67, v67, s14
    v_and_b32 v112, v111, v96
    v_and_b32 v113, v111, v97
    v_and_b32 v114, v111, v98
    v_and_b32 v115, v111, v99
    s_nop 1
    v_mfma_f32_16x16x32_bf16 v[104:107], v[112:115], v[28:31], v[104:107]
    v_perm_b32 v110, v60, v60, s13
    v_and_b32 v116, v110, v96
    v_and_b32 v117, v110, v97
    v_and_b32 v118, v110, v98
    v_and_b32 v119, v110, v99
    s_nop 1
    v_mfma_f32_16x16x32_bf16 v[100:103], v[116:119], v[32:35], v[100:103]
    v_perm_b32 v111, v68, v68, s13
    v_and_b32 v112, v111, v96
    v_and_b32 v113, v111, v97
    v_and_b32 v114, v111, v98
    v_and_b32 v115, v111, v99
    s_nop 1
    v_mfma_f32_16x16x32_bf16 v[104:107], v[112:115], v[32:35], v[104:107]
    v_perm_b32 v110, v60, v60, s14
    v_and_b32 v116, v110, v96
    v_and_b32 v117, v110, v97
    v_and_b32 v118, v110, v98
    v_and_b32 v119, v110, v99
    s_nop 1
    v_mfma_f32_16x16x32_bf16 v[100:103], v[116:119], v[36:39], v[100:103]
    v_perm_b32 v111, v68, v68, s14
    v_and_b32 v112, v111, v96
    v_and_b32 v113, v111, v97
    v_and_b32 v114, v111, v98
    v_and_b32 v115, v111, v99
    s_nop 1
    v_mfma_f32_16x16x32_bf16 v[104:107], v[112:115], v[36:39], v[104:107]
    v_perm_b32 v110, v61, v61, s13
    v_and_b32 v116, v110, v96
    v_and_b32 v117, v110, v97
    v_and_b32 v118, v110, v98
    v_and_b32 v119, v110, v99
    s_nop 1
    v_mfma_f32_16x16x32_bf16 v[100:103], v[116:119], v[40:43], v[100:103]
    v_perm_b32 v111, v69, v69, s13
    v_and_b32 v112, v111, v96
    v_and_b32 v113, v111, v97
    v_and_b32 v114, v111, v98
    v_and_b32 v115, v111, v99
    s_nop 1
    v_mfma_f32_16x16x32_bf16 v[104:107], v[112:115], v[40:43], v[104:107]
    v_perm_b32 v110, v61, v61, s14
    v_and_b32 v116, v110, v96
    v_and_b32 v117, v110, v97
    v_and_b32 v118, v110, v98
    v_and_b32 v119, v110, v99
    s_nop 1
    v_mfma_f32_16x16x32_bf16 v[100:103], v[116:119], v[44:47], v[100:103]
    v_perm_b32 v111, v69, v69, s14
    v_and_b32 v112, v111, v96
    v_and_b32 v113, v111, v97
    v_and_b32 v114, v111, v98
    v_and_b32 v115, v111, v99
    s_nop 1
    v_mfma_f32_16x16x32_bf16 v[104:107], v[112:115], v[44:47], v[104:107]
    v_perm_b32 v110, v62, v62, s13
    v_and_b32 v116, v110, v96
    v_and_b32 v117, v110, v97
    v_and_b32 v118, v110, v98
    v_and_b32 v119, v110, v99
    s_nop 1
    v_mfma_f32_16x16x32_bf16 v[100:103], v[116:119], v[48:51], v[100:103]
    v_perm_b32 v111, v70, v70, s13
    v_and_b32 v112, v111, v96
    v_and_b32 v113, v111, v97
    v_and_b32 v114, v111, v98
    v_and_b32 v115, v111, v99
    s_nop 1
    v_mfma_f32_16x16x32_bf16 v[104:107], v[112:115], v[48:51], v[104:107]
    v_perm_b32 v110, v62, v62, s14
    v_and_b32 v116, v110, v96
    v_and_b32 v117, v110, v97
    v_and_b32 v118, v110, v98
    v_and_b32 v119, v110, v99
    s_nop 1
    v_mfma_f32_16x16x32_bf16 v[100:103], v[116:119], v[52:55], v[100:103]
    v_perm_b32 v111, v70, v70, s14
    v_and_b32 v112, v111, v96
    v_and_b32 v113, v111, v97
    v_and_b32 v114, v111, v98
    v_and_b32 v115, v111, v99
    s_nop 1
    v_mfma_f32_16x16x32_bf16 v[104:107], v[112:115], v[52:55], v[104:107]
    s_cmp_eq_u32 s10, 1
    s_nop 6
    v_permlane32_swap_b32 v100, v104
    v_permlane32_swap_b32 v101, v105
    v_permlane32_swap_b32 v102, v106
    v_permlane32_swap_b32 v103, v107
    v_add_f32_dpp v100, v104, v100 row_ror:8 row_mask:0xf bank_mask:0xf
    v_add_f32_dpp v101, v105, v101 row_ror:8 row_mask:0xf bank_mask:0xf
    v_add_f32_dpp v102, v106, v102 row_ror:8 row_mask:0xf bank_mask:0xf
    v_add_f32_dpp v103, v107, v103 row_ror:8 row_mask:0xf bank_mask:0xf
    v_add_u32 v100, 0x80, v100
    v_add_u32 v101, 0x80, v101
    v_add_u32 v102, 0x80, v102
    v_add_u32 v103, 0x80, v103
    v_perm_b32 v100, v100, v108, s40
    v_perm_b32 v101, v101, v108, s41
    v_perm_b32 v102, v102, v108, s60
    v_perm_b32 v103, v103, v108, s61
    s_mov_b32 exec_lo, 0x00ff00ff
    s_mov_b32 exec_hi, 0x00ff00ff
    buffer_store_dwordx4 v[100:103], v127, s[52:55], s82 offen sc1
    s_mov_b64 exec, -1
    s_cbranch_scc1 L_hgather
    buffer_load_dwordx4 v[0:3], v124, s[44:47], s72 offen offset:0 nt
    buffer_load_dwordx4 v[4:7], v124, s[44:47], s72 offen offset:128 nt
    buffer_load_dwordx4 v[8:11], v124, s[44:47], s72 offen offset:256 nt
    buffer_load_dwordx4 v[12:15], v124, s[44:47], s72 offen offset:384 nt
    buffer_load_dwordx4 v[16:19], v124, s[44:47], s73 offen offset:0 nt
    buffer_load_dwordx4 v[20:23], v124, s[44:47], s73 offen offset:128 nt
    buffer_load_dwordx4 v[24:27], v124, s[44:47], s73 offen offset:256 nt
    buffer_load_dwordx4 v[28:31], v124, s[44:47], s73 offen offset:384 nt
    buffer_load_dwordx4 v[32:35], v124, s[44:47], s74 offen offset:0 nt
    buffer_load_dwordx4 v[36:39], v124, s[44:47], s74 offen offset:128 nt
    buffer_load_dwordx4 v[40:43], v124, s[44:47], s74 offen offset:256 nt
    buffer_load_dwordx4 v[44:47], v124, s[44:47], s74 offen offset:384 nt
    buffer_load_dwordx4 v[48:51], v124, s[44:47], s75 offen offset:0 nt
    buffer_load_dwordx4 v[52:55], v124, s[44:47], s75 offen offset:128 nt
    buffer_load_dwordx4 v[56:59], v124, s[44:47], s75 offen offset:256 nt
    buffer_load_dwordx4 v[60:63], v124, s[44:47], s75 offen offset:384 nt
    buffer_load_dwordx4 v[64:67], v109, s[52:55], s83 offen offset:0 sc1
    buffer_load_dwordx4 v[68:71], v109, s[52:55], s83 offen offset:1024 sc1
    buffer_load_dwordx4 v[72:75], v109, s[52:55], s83 offen offset:2048 sc1
    buffer_load_dwordx4 v[76:79], v109, s[52:55], s83 offen offset:3072 sc1
    s_mov_b32 s87, 0
L_qp:
    s_waitcnt vmcnt(0)
    s_mov_b32 s62, 0
    v_perm_b32 v112, v65, v64, s3
    v_perm_b32 v113, v67, v66, s4
    v_or_b32 v112, v112, v113
    v_cmp_ne_u32 vcc, s92, v112
    s_nop 0
    s_cbranch_vccz L_qp_s0
    s_mov_b64 exec, vcc
    buffer_load_dwordx4 v[64:67], v109, s[52:55], s83 offen offset:0 sc1
    s_mov_b64 exec, -1
    s_mov_b32 s62, 1
L_qp_s0:
    v_perm_b32 v112, v69, v68, s3
    v_perm_b32 v113, v71, v70, s4
    v_or_b32 v112, v112, v113
    v_cmp_ne_u32 vcc, s92, v112
    s_nop 0
    s_cbranch_vccz L_qp_s1
    s_mov_b64 exec, vcc
    buffer_load_dwordx4 v[68:71], v109, s[52:55], s83 offen offset:1024 sc1
    s_mov_b64 exec, -1
    s_mov_b32 s62, 1
L_qp_s1:
    v_perm_b32 v112, v73, v72, s3
    v_perm_b32 v113, v75, v74, s4
    v_or_b32 v112, v112, v113
    v_cmp_ne_u32 vcc, s92, v112
    s_nop 0
    s_cbranch_vccz L_qp_s2
    s_mov_b64 exec, vcc
    buffer_load_dwordx4 v[72:75], v109, s[52:55], s83 offen offset:2048 sc1
    s_mov_b64 exec, -1
    s_mov_b32 s62, 1
L_qp_s2:
    v_perm_b32 v112, v77, v76, s3
    v_perm_b32 v113, v79, v78, s4
    v_or_b32 v112, v112, v113
    v_cmp_ne_u32 vcc, s92, v112
    s_nop 0
    s_cbranch_vccz L_qp_s3
    s_mov_b64 exec, vcc
    buffer_load_dwordx4 v[76:79], v109, s[52:55], s83 offen offset:3072 sc1
    s_mov_b64 exec, -1
    s_mov_b32 s62, 1
L_qp_s3:
    s_cmp_eq_u32 s62, 0
    s_cbranch_scc1 L_qp_ok
    s_add_u32 s87, s87, 1
    s_cmp_gt_u32 s87, 8388608
    s_cbranch_scc0 L_qp
    s_waitcnt vmcnt(0)
L_qp_ok:
    v_and_b32 v64, s94, v64
    v_and_b32 v65, s94, v65
    v_and_b32 v66, s94, v66
    v_and_b32 v67, s94, v67
    v_and_b32 v68, s94, v68
    v_and_b32 v69, s94, v69
    v_and_b32 v70, s94, v70
    v_and_b32 v71, s94, v71
    v_and_b32 v72, s94, v72
    v_and_b32 v73, s94, v73
    v_and_b32 v74, s94, v74
    v_and_b32 v75, s94, v75
    v_and_b32 v76, s94, v76
    v_and_b32 v77, s94, v77
    v_and_b32 v78, s94, v78
    v_and_b32 v79, s94, v79
    v_add_f32 v64, v64, v68
    v_add_f32 v65, v65, v69
    v_add_f32 v66, v66, v70
    v_add_f32 v67, v67, v71
    v_add_f32 v64, v64, v72
    v_add_f32 v65, v65, v73
    v_add_f32 v66, v66, v74
    v_add_f32 v67, v67, v75
    v_add_f32 v64, v64, v76
    v_add_f32 v65, v65, v77
    v_add_f32 v66, v66, v78
    v_add_f32 v67, v67, v79
    v_cvt_pk_bf16_f32 v108, v64, v65
    v_cvt_pk_bf16_f32 v109, v66, v67
    v_lshlrev_b32 v127, 3, v126
    ds_write_b64 v127, v[108:109] offset:0
    s_branch L_kdone
L_hgather:
    buffer_load_dwordx4 v[0:3], v124, s[44:47], s72 offen offset:0 nt
    buffer_load_dwordx4 v[4:7], v124, s[44:47], s72 offen offset:128 nt
    buffer_load_dwordx4 v[8:11], v124, s[44:47], s72 offen offset:256 nt
    buffer_load_dwordx4 v[12:15], v124, s[44:47], s72 offen offset:384 nt
    buffer_load_dwordx4 v[16:19], v124, s[44:47], s73 offen offset:0 nt
    buffer_load_dwordx4 v[20:23], v124, s[44:47], s73 offen offset:128 nt
    buffer_load_dwordx4 v[24:27], v124, s[44:47], s73 offen offset:256 nt
    buffer_load_dwordx4 v[28:31], v124, s[44:47], s73 offen offset:384 nt
    buffer_load_dwordx4 v[32:35], v124, s[44:47], s74 offen offset:0 nt
    buffer_load_dwordx4 v[36:39], v124, s[44:47], s74 offen offset:128 nt
    buffer_load_dwordx4 v[40:43], v124, s[44:47], s74 offen offset:256 nt
    buffer_load_dwordx4 v[44:47], v124, s[44:47], s74 offen offset:384 nt
    buffer_load_dwordx4 v[48:51], v124, s[44:47], s75 offen offset:0 nt
    buffer_load_dwordx4 v[52:55], v124, s[44:47], s75 offen offset:128 nt
    buffer_load_dwordx4 v[56:59], v124, s[44:47], s75 offen offset:256 nt
    buffer_load_dwordx4 v[60:63], v124, s[44:47], s75 offen offset:384 nt
    v_and_b32 v116, 7, v126
    v_bfe_u32 v108, v126, 3, 2
    v_lshlrev_b32 v108, 10, v108
    v_lshl_add_u32 v108, v116, 4, v108
    s_lshl_b32 s11, s7, 6
    s_add_u32 s83, s83, s11
    s_lshl_b32 s12, s93, 8
    s_lshl_b32 s11, s7, 5
    s_add_u32 s12, s12, s11
    v_lshlrev_b32 v127, 3, v116
    v_add_u32 v127, s12, v127
    global_load_dwordx2 v[118:119], v127, s[30:31]
    buffer_load_dwordx4 v[100:103], v108, s[52:55], s83 offen sc1
    s_mov_b32 s87, 0
L_hp:
    s_waitcnt vmcnt(0)
    s_mov_b32 s62, 0
    v_perm_b32 v112, v101, v100, s3
    v_perm_b32 v113, v103, v102, s4
    v_or_b32 v112, v112, v113
    v_cmp_ne_u32 vcc, s92, v112
    s_nop 0
    s_cbranch_vccz L_hp_s0
    s_mov_b64 exec, vcc
    buffer_load_dwordx4 v[100:103], v108, s[52:55], s83 offen sc1
    s_mov_b64 exec, -1
    s_mov_b32 s62, 1
L_hp_s0:
    s_cmp_eq_u32 s62, 0
    s_cbranch_scc1 L_hp_ok
    s_add_u32 s87, s87, 1
    s_cmp_gt_u32 s87, 8388608
    s_cbranch_scc0 L_hp
    s_waitcnt vmcnt(0)
L_hp_ok:
    v_and_b32 v100, s94, v100
    v_and_b32 v101, s94, v101
    v_and_b32 v102, s94, v102
    v_and_b32 v103, s94, v103
    v_add_f32_dpp v100, v100, v100 row_ror:8 row_mask:0xf bank_mask:0xf
    v_add_f32_dpp v101, v101, v101 row_ror:8 row_mask:0xf bank_mask:0xf
    v_add_f32_dpp v102, v102, v102 row_ror:8 row_mask:0xf bank_mask:0xf
    v_add_f32_dpp v103, v103, v103 row_ror:8 row_mask:0xf bank_mask:0xf
    v_mov_b32 v104, v100
    v_mov_b32 v105, v101
    v_mov_b32 v106, v102
    v_mov_b32 v107, v103
    v_permlane16_swap_b32 v100, v104
    v_permlane16_swap_b32 v101, v105
    v_permlane16_swap_b32 v102, v106
    v_permlane16_swap_b32 v103, v107
    v_add_f32 v100, v100, v104
    v_add_f32 v101, v101, v105
    v_add_f32 v102, v102, v106
    v_add_f32 v103, v103, v107
    v_cvt_pk_bf16_f32 v112, v100, v101
    v_lshlrev_b32 v100, 16, v112
    v_and_b32 v101, s79, v112
    v_cvt_pk_bf16_f32 v113, v102, v103
    v_lshlrev_b32 v102, 16, v113
    v_and_b32 v103, s79, v113
    v_lshlrev_b32 v104, 16, v118
    v_and_b32 v105, s79, v118
    v_lshlrev_b32 v106, 16, v119
    v_and_b32 v107, s79, v119
    v_add_f32 v100, v100, v104
    v_add_f32 v101, v101, v105
    v_add_f32 v102, v102, v106
    v_add_f32 v103, v103, v107
    v_cvt_pk_bf16_f32 v112, v100, v101
    v_lshlrev_b32 v100, 16, v112
    v_and_b32 v101, s79, v112
    v_cvt_pk_bf16_f32 v113, v102, v103
    v_lshlrev_b32 v102, 16, v113
    v_and_b32 v103, s79, v113
    v_max_f32 v100, 0, v100
    v_max_f32 v101, 0, v101
    v_max_f32 v102, 0, v102
    v_max_f32 v103, 0, v103
    v_mul_f32 v100, v100, v100
    v_mul_f32 v101, v101, v101
    v_mul_f32 v102, v102, v102
    v_mul_f32 v103, v103, v103
    v_lshlrev_b32 v127, 4, v116
    ds_write_b128 v127, v[100:103] offset:640
    s_nop 1
    s_branch L_kdone
L_end:
    s_endpgm
.section .rodata,"a"
.p2align 6
.amdhsa_kernel gated_mix__mha_block_cached__dense_activation_squared_relu__decode_kernel
  .amdhsa_next_free_vgpr 128
  .amdhsa_next_free_sgpr 102
  .amdhsa_accum_offset 128
  .amdhsa_group_segment_fixed_size 0
  .amdhsa_kernarg_size 112
  .amdhsa_user_sgpr_count 2
  .amdhsa_user_sgpr_kernarg_segment_ptr 1
  .amdhsa_system_sgpr_workgroup_id_x 1
  .amdhsa_float_denorm_mode_32 3
.end_amdhsa_kernel
```
